```python
import torch

def _softmax(x, axis=-1):
    return torch.softmax(x, dim=axis)
def _gelu(x):
    return torch.nn.functional.gelu(x, approximate="tanh")
def _silu(x):
    return torch.nn.functional.silu(x)
def _sigmoid(x):
    return torch.sigmoid(x)
def _layernorm(x, axis=-1, eps=1e-5):
    m = x.mean(dim=axis, keepdim=True)
    v = x.var(dim=axis, keepdim=True, unbiased=False)
    return (x - m) / torch.sqrt(v + eps)
def _scatter_add(tgt, idx, src, axis=0):
    return tgt.clone().index_add_(axis, idx, src)
def _segment_sum(src, seg, n):
    out = torch.zeros((n,) + src.shape[1:], dtype=src.dtype)
    return out.index_add_(0, seg, src)
def _pad(x, pw):
    flat = tuple(v for pair in reversed(pw) for v in pair)
    return torch.nn.functional.pad(x, flat)

kernel_name = 'gated_mix__sliding_block_cached__glu_gated_reglu__decode'

def setup_inputs():

    _w = (lambda a: (lambda t: t.to(torch.bfloat16) if t.is_floating_point() else t)(torch.as_tensor(a)))
    def _A_setup():
        B, Sq, D = 2, 1, 512
        Hq, Hkv, Sk, Dh = 32, 32, 4096, 128
        assert Hq % Hkv == 0, (Hq, Hkv)
        return {
            "x": _w((lambda *s: torch.randn(*s, dtype=torch.bfloat16) * 0.05)(B, Sq, D)),
            "k_cache": _w((lambda *s: torch.randn(*s, dtype=torch.bfloat16) * 3.2)(B, Hkv, Sk, Dh)),
            "v_cache": _w((lambda *s: torch.randn(*s, dtype=torch.bfloat16) * 0.05)(B, Hkv, Sk, Dh)),
            "wq": _w((lambda *s: torch.randn(*s, dtype=torch.bfloat16) * 3.2)(D, Hq * Dh) * (D ** -0.5)),
            "wo": _w((lambda *s: torch.randn(*s, dtype=torch.bfloat16) * 0.05)(Hq * Dh, D) * ((Hq * Dh) ** -0.5)),
        }
    _A_in = _A_setup()

    def _B_setup():
        B, S, D, F = 2, 1, 512, 1376
        return {
            "x": _w((lambda *s: torch.randn(*s, dtype=torch.bfloat16) * 0.05)(B, S, D)),
            "W_gate": _w((lambda *s: torch.randn(*s, dtype=torch.bfloat16) * 0.2)(D, F) * (2.0 / D) ** 0.5),
            "W_up": _w((lambda *s: torch.randn(*s, dtype=torch.bfloat16) * 0.2)(D, F) * (2.0 / D) ** 0.5),
            "W_down": _w((lambda *s: torch.randn(*s, dtype=torch.bfloat16) * 0.2)(F, D) * (1.0 / F) ** 0.5),
        }
    _B_in = _B_setup()

    return {
        "A_x": _A_in["x"],
        "A_k_cache": _A_in["k_cache"],
        "A_v_cache": _A_in["v_cache"],
        "A_wq": _A_in["wq"],
        "A_wo": _A_in["wo"],
        "B_x": _B_in["x"],
        "B_W_gate": _B_in["W_gate"],
        "B_W_up": _B_in["W_up"],
        "B_W_down": _B_in["W_down"],
        "gate_w": _w((lambda *s: torch.randn(*s, dtype=torch.bfloat16) * 0.05)(512) * 16.0),
    }

def reference(A_x, A_k_cache, A_v_cache, A_wq, A_wo, B_x, B_W_gate, B_W_up, B_W_down, gate_w):
    def _A_ref(x, k_cache, v_cache, wq, wo):
        B, Sq, D = x.shape
        Hq, Dh = 32, 128
        Hkv, Sk = k_cache.shape[1], k_cache.shape[2]
        W = min(4096, max(256, Sk // 4))
        rep = Hq // Hkv
        q = (lambda x, *d: x.permute(*d))((x @ wq).reshape(B, Sq, Hq, Dh), 0, 2, 1, 3)
        k = (lambda x, n, axis: torch.repeat_interleave(x, n, dim=axis))(k_cache[:, :, Sk - W:, :], rep, axis=1)
        v = (lambda x, n, axis: torch.repeat_interleave(x, n, dim=axis))(v_cache[:, :, Sk - W:, :], rep, axis=1)
        scores = torch.einsum("bhqd,bhkd->bhqk", q, k) * (Dh ** -0.5)
        p = _softmax(scores, axis=-1)
        o = torch.einsum("bhqk,bhkd->bhqd", p, v)
        return (lambda x, *d: x.permute(*d))(o, 0, 2, 1, 3).reshape(B, Sq, Hq * Dh) @ wo

    def _B_ref(x, W_gate, W_up, W_down):
        gate = torch.einsum("bsd,df->bsf", x, W_gate)
        up = torch.einsum("bsd,df->bsf", x, W_up)
        gate = gate * (lambda x, dt: x.to(dt))(gate > 0, gate.dtype)
        h = gate * up
        return torch.einsum("bsf,fd->bsd", h, W_down)

    x = A_x
    g = _sigmoid((x * gate_w).sum(-1, keepdims=True))
    a = _A_ref(x, A_k_cache, A_v_cache, A_wq, A_wo)
    b = _B_ref(x, B_W_gate, B_W_up, B_W_down)
    return g * a + (1 - g) * b
```

```asm
; @launch grid=(256,1,1) block=(320,1,1) lds=157696
.amdgcn_target "amdgcn-amd-amdhsa--gfx950"
.text
.globl gated_mix__sliding_block_cached__glu_gated_reglu__decode_kernel
.p2align 8
.type gated_mix__sliding_block_cached__glu_gated_reglu__decode_kernel,@function
gated_mix__sliding_block_cached__glu_gated_reglu__decode_kernel:
    s_cmp_ge_u32 s2, 256
    s_cbranch_scc1 L_exit
    s_load_dwordx16 s[8:23], s[0:1], 0
    s_load_dwordx4 s[24:27], s[0:1], 64
    s_load_dwordx2 s[28:29], s[0:1], 80
    s_load_dwordx2 s[30:31], s[0:1], 96

    v_lshrrev_b32 v1, 6, v0
    v_and_b32 v0, 63, v0
    s_and_b32 s62, s2, 7
    s_lshr_b32 s63, s2, 3
    v_readfirstlane_b32 s3, v1
    s_lshr_b32 s4, s63, 3
    s_lshl_b32 s62, s62, 2
    s_add_u32 s4, s4, s62
    s_and_b32 s5, s63, 7

    v_mov_b32 v4, 0
    v_mov_b32 v5, 0
    v_mov_b32 v6, 0
    v_mov_b32 v7, 0
    v_mov_b32 v26, 155648
    s_mov_b64 exec, 1
    ds_write_b128 v26, v[4:7]
    ds_write_b64 v26, v[4:5] offset:56
    s_mov_b64 exec, -1
    v_lshrrev_b32 v1, 4, v0
    v_and_b32 v2, 15, v0
    v_lshrrev_b32 v3, 1, v2
    v_xor_b32 v3, v3, v1
    v_and_b32 v5, 1, v0
    v_lshlrev_b32 v5, 4, v5
    v_lshl_or_b32 v6, v3, 5, v5
    v_xor_b32 v7, 0x80, v6
    v_lshl_add_u32 v8, v1, 13, v6
    v_lshl_add_u32 v9, v1, 13, v7
    s_lshl_b32 s66, s5, 19
    s_lshl_b32 s62, s4, 8
    s_add_u32 s66, s66, s62
    s_mov_b32 s69, -23
    s_mov_b32 s100, 0
    s_mov_b32 s61, 1000000
    s_mov_b32 s42, 4194304
    s_mov_b32 s43, 0x20000
    s_cmp_lg_u32 s3, 0
    s_waitcnt lgkmcnt(0)
    s_barrier
    s_cbranch_scc1 L_compute
    s_mov_b32 s40, s14
    s_mov_b32 s41, s15
    s_setprio 3

    s_mov_b32 m0, 98304
    s_mov_b32 s68, 4
L_ld_wq:
    buffer_load_dwordx4 v8, s[40:43], s66 offen nt lds
    s_add_u32 m0, m0, 1024
    s_add_u32 s66, s66, 32768
    s_waitcnt vmcnt(23)
    buffer_load_dwordx4 v8, s[40:43], s66 offen nt lds
    s_add_u32 m0, m0, 1024
    s_add_u32 s66, s66, 32768
    s_waitcnt vmcnt(23)
    buffer_load_dwordx4 v9, s[40:43], s66 offen nt lds
    s_add_u32 m0, m0, 1024
    s_add_u32 s66, s66, 32768
    s_waitcnt vmcnt(23)
    buffer_load_dwordx4 v9, s[40:43], s66 offen nt lds
    s_add_u32 m0, m0, 1024
    s_add_u32 s66, s66, 32768
    s_waitcnt vmcnt(23)
    s_add_i32 s69, s69, 4
    s_max_i32 s100, s69, s100
    v_mov_b32 v27, s100
    s_mov_b64 exec, 1
    ds_write_b32 v26, v27 offset:0
    s_mov_b64 exec, -1
    s_sub_u32 s68, s68, 1
    s_cmp_lg_u32 s68, 0
    s_cbranch_scc1 L_ld_wq

    v_lshl_add_u32 v10, v1, 8, v6
    v_lshl_add_u32 v11, v1, 8, v7
    v_lshrrev_b32 v20, 3, v0
    v_and_b32 v21, 7, v0
    v_lshrrev_b32 v21, 1, v21
    v_and_b32 v22, 1, v1
    v_xor_b32 v21, v21, v22
    v_mul_u32_u24 v23, 2752, v20
    v_mov_b32 v24, 0x7fff0000

    s_lshr_b32 s62, s4, 2
    s_lshl_b32 s63, s62, 2
    s_lshr_b32 s70, 0x55565656, s63
    s_and_b32 s70, s70, 15
    s_lshl_b32 s63, s62, 3
    s_mov_b32 s64, 0x110b0600
    s_mov_b32 s65, 0x26211c16
    s_lshr_b64 s[64:65], s[64:65], s63
    s_and_b32 s60, s64, 0xff
    s_lshl_b32 s60, s60, 2
    s_and_b32 s62, s4, 3
    s_mul_i32 s62, s62, s70
    s_add_u32 s60, s60, s62

    v_xor_b32 v22, 0, v21
    v_lshl_or_b32 v25, v22, 5, v5
    v_lshrrev_b32 v22, 4, v25
    v_cmp_le_u32 vcc, s70, v22
    v_lshl_add_u32 v16, v20, 10, v25
    v_add_u32 v18, v23, v25
    v_cndmask_b32 v18, v18, v24, vcc

    v_xor_b32 v22, 2, v21
    v_lshl_or_b32 v25, v22, 5, v5
    v_lshrrev_b32 v22, 4, v25
    v_cmp_le_u32 vcc, s70, v22
    v_lshl_add_u32 v17, v20, 10, v25
    v_add_u32 v19, v23, v25
    v_cndmask_b32 v19, v19, v24, vcc

    s_mov_b32 s48, s20
    s_mov_b32 s49, s21
    s_mov_b32 s50, 1409024
    s_mov_b32 s51, 0x20000

    s_mov_b32 s52, s22
    s_mov_b32 s53, s23
    s_mov_b32 s54, 1409024
    s_mov_b32 s55, 0x20000

    s_mov_b32 m0, 114688
    s_mul_i32 s66, s5, 176128
    s_lshl_b32 s62, s60, 4
    s_add_u32 s66, s66, s62
    s_mov_b32 s68, 2
L_ld_wg:
    buffer_load_dwordx4 v18, s[48:51], s66 offen nt lds
    s_add_u32 m0, m0, 1024
    s_add_u32 s66, s66, 22016
    s_waitcnt vmcnt(23)
    buffer_load_dwordx4 v19, s[48:51], s66 offen nt lds
    s_add_u32 m0, m0, 1024
    s_add_u32 s66, s66, 22016
    s_waitcnt vmcnt(23)
    buffer_load_dwordx4 v18, s[48:51], s66 offen nt lds
    s_add_u32 m0, m0, 1024
    s_add_u32 s66, s66, 22016
    s_waitcnt vmcnt(23)
    buffer_load_dwordx4 v19, s[48:51], s66 offen nt lds
    s_add_u32 m0, m0, 1024
    s_add_u32 s66, s66, 22016
    s_waitcnt vmcnt(23)
    s_add_i32 s69, s69, 4
    s_max_i32 s100, s69, s100
    v_mov_b32 v27, s100
    s_mov_b64 exec, 1
    ds_write_b32 v26, v27 offset:0
    s_mov_b64 exec, -1
    s_sub_u32 s68, s68, 1
    s_cmp_lg_u32 s68, 0
    s_cbranch_scc1 L_ld_wg

    s_mov_b32 m0, 122880
    s_mul_i32 s66, s5, 176128
    s_lshl_b32 s62, s60, 4
    s_add_u32 s66, s66, s62
    s_mov_b32 s68, 2
L_ld_wu:
    buffer_load_dwordx4 v18, s[52:55], s66 offen nt lds
    s_add_u32 m0, m0, 1024
    s_add_u32 s66, s66, 22016
    s_waitcnt vmcnt(23)
    buffer_load_dwordx4 v19, s[52:55], s66 offen nt lds
    s_add_u32 m0, m0, 1024
    s_add_u32 s66, s66, 22016
    s_waitcnt vmcnt(23)
    buffer_load_dwordx4 v18, s[52:55], s66 offen nt lds
    s_add_u32 m0, m0, 1024
    s_add_u32 s66, s66, 22016
    s_waitcnt vmcnt(23)
    buffer_load_dwordx4 v19, s[52:55], s66 offen nt lds
    s_add_u32 m0, m0, 1024
    s_add_u32 s66, s66, 22016
    s_waitcnt vmcnt(23)
    s_add_i32 s69, s69, 4
    s_max_i32 s100, s69, s100
    v_mov_b32 v27, s100
    s_mov_b64 exec, 1
    ds_write_b32 v26, v27 offset:0
    s_mov_b64 exec, -1
    s_sub_u32 s68, s68, 1
    s_cmp_lg_u32 s68, 0
    s_cbranch_scc1 L_ld_wu

    v_xor_b32 v6, v2, v1
    v_xor_b32 v7, 0, v6
    v_lshlrev_b32 v7, 4, v7
    v_lshl_add_u32 v12, v1, 8, v7
    v_xor_b32 v7, 4, v6
    v_lshlrev_b32 v7, 4, v7
    v_lshl_add_u32 v13, v1, 8, v7
    v_xor_b32 v7, 8, v6
    v_lshlrev_b32 v7, 4, v7
    v_lshl_add_u32 v14, v1, 8, v7
    v_xor_b32 v7, 12, v6
    v_lshlrev_b32 v7, 4, v7
    v_lshl_add_u32 v15, v1, 8, v7
    s_lshr_b32 s62, s5, 2
    s_lshl_b32 s62, s62, 5
    s_add_u32 s62, s62, s4
    s_lshl_b32 s67, s62, 20
    s_and_b32 s62, s5, 3
    s_lshl_b32 s62, s62, 16
    s_add_u32 s67, s67, s62
    s_add_u32 s67, s67, 0xC0000

    s_mov_b32 s32, s10
    s_mov_b32 s33, s11
    s_mov_b32 s34, 67108864
    s_mov_b32 s35, 0x20000

    s_mov_b32 s36, s12
    s_mov_b32 s37, s13
    s_mov_b32 s38, 67108864
    s_mov_b32 s39, 0x20000

    s_mov_b32 m0, 0
    s_mul_i32 s101, s2, 17
    s_and_b32 s101, s101, 63
    s_lshl_b32 s101, s101, 10
    s_add_u32 s66, s67, s101
    s_mov_b32 s68, 16
L_ld_k:
    buffer_load_dwordx4 v12, s[32:35], s66 offen nt lds
    s_add_u32 m0, m0, 1024
    s_add_u32 s101, s101, 1024
    s_and_b32 s101, s101, 0xffff
    s_add_u32 s66, s67, s101
    s_waitcnt vmcnt(23)
    buffer_load_dwordx4 v13, s[32:35], s66 offen nt lds
    s_add_u32 m0, m0, 1024
    s_add_u32 s101, s101, 1024
    s_and_b32 s101, s101, 0xffff
    s_add_u32 s66, s67, s101
    s_waitcnt vmcnt(23)
    buffer_load_dwordx4 v14, s[32:35], s66 offen nt lds
    s_add_u32 m0, m0, 1024
    s_add_u32 s101, s101, 1024
    s_and_b32 s101, s101, 0xffff
    s_add_u32 s66, s67, s101
    s_waitcnt vmcnt(23)
    buffer_load_dwordx4 v15, s[32:35], s66 offen nt lds
    s_add_u32 m0, m0, 1024
    s_add_u32 s101, s101, 1024
    s_and_b32 s101, s101, 0xffff
    s_add_u32 s66, s67, s101
    s_waitcnt vmcnt(23)
    s_add_i32 s69, s69, 4
    s_max_i32 s100, s69, s100
    v_mov_b32 v27, s100
    s_mov_b64 exec, 1
    ds_write_b32 v26, v27 offset:0
    s_mov_b64 exec, -1
    s_sub_u32 s68, s68, 1
    s_cmp_lg_u32 s68, 0
    s_cbranch_scc1 L_ld_k

    s_mov_b32 s44, s16
    s_mov_b32 s45, s17
    s_mov_b32 s46, 4194304
    s_mov_b32 s47, 0x20000

    s_mov_b32 s56, s24
    s_mov_b32 s57, s25
    s_mov_b32 s58, 1409024
    s_mov_b32 s59, 0x20000

    s_mov_b32 m0, 65536
    s_mul_i32 s101, s2, 17
    s_and_b32 s101, s101, 63
    s_lshl_b32 s101, s101, 10
    s_add_u32 s66, s67, s101
    s_mov_b32 s68, 8
L_ld_v0:
    buffer_load_dwordx4 v10, s[36:39], s66 offen nt lds
    s_add_u32 m0, m0, 1024
    s_add_u32 s101, s101, 1024
    s_and_b32 s101, s101, 0xffff
    s_add_u32 s66, s67, s101
    s_waitcnt vmcnt(23)
    buffer_load_dwordx4 v10, s[36:39], s66 offen nt lds
    s_add_u32 m0, m0, 1024
    s_add_u32 s101, s101, 1024
    s_and_b32 s101, s101, 0xffff
    s_add_u32 s66, s67, s101
    s_waitcnt vmcnt(23)
    buffer_load_dwordx4 v11, s[36:39], s66 offen nt lds
    s_add_u32 m0, m0, 1024
    s_add_u32 s101, s101, 1024
    s_and_b32 s101, s101, 0xffff
    s_add_u32 s66, s67, s101
    s_waitcnt vmcnt(23)
    buffer_load_dwordx4 v11, s[36:39], s66 offen nt lds
    s_add_u32 m0, m0, 1024
    s_add_u32 s101, s101, 1024
    s_and_b32 s101, s101, 0xffff
    s_add_u32 s66, s67, s101
    s_waitcnt vmcnt(23)
    s_add_i32 s69, s69, 4
    s_max_i32 s100, s69, s100
    v_mov_b32 v27, s100
    s_mov_b64 exec, 1
    ds_write_b32 v26, v27 offset:0
    s_mov_b64 exec, -1
    s_sub_u32 s68, s68, 1
    s_cmp_lg_u32 s68, 0
    s_cbranch_scc1 L_ld_v0

    L_ld_s1:
    ds_read_b32 v27, v26 offset:4
    s_waitcnt lgkmcnt(0)
    v_readfirstlane_b32 s62, v27
    s_cmp_ge_u32 s62, 4
    s_cbranch_scc1 L_ld_s1_ok
    s_sub_u32 s61, s61, 1
    s_cbranch_scc1 L_exit
    s_sleep 1
    s_branch L_ld_s1
    L_ld_s1_ok:
    s_add_i32 s69, s69, 0

    s_mov_b32 m0, 98304
    s_nop 0
    s_mov_b32 s68, 8
L_ld_v:
    buffer_load_dwordx4 v10, s[36:39], s66 offen nt lds
    s_add_u32 m0, m0, 1024
    s_add_u32 s101, s101, 1024
    s_and_b32 s101, s101, 0xffff
    s_add_u32 s66, s67, s101
    s_waitcnt vmcnt(23)
    buffer_load_dwordx4 v10, s[36:39], s66 offen nt lds
    s_add_u32 m0, m0, 1024
    s_add_u32 s101, s101, 1024
    s_and_b32 s101, s101, 0xffff
    s_add_u32 s66, s67, s101
    s_waitcnt vmcnt(23)
    buffer_load_dwordx4 v11, s[36:39], s66 offen nt lds
    s_add_u32 m0, m0, 1024
    s_add_u32 s101, s101, 1024
    s_and_b32 s101, s101, 0xffff
    s_add_u32 s66, s67, s101
    s_waitcnt vmcnt(23)
    buffer_load_dwordx4 v11, s[36:39], s66 offen nt lds
    s_add_u32 m0, m0, 1024
    s_add_u32 s101, s101, 1024
    s_and_b32 s101, s101, 0xffff
    s_add_u32 s66, s67, s101
    s_waitcnt vmcnt(23)
    s_add_i32 s69, s69, 4
    s_max_i32 s100, s69, s100
    v_mov_b32 v27, s100
    s_mov_b64 exec, 1
    ds_write_b32 v26, v27 offset:0
    s_mov_b64 exec, -1
    s_sub_u32 s68, s68, 1
    s_cmp_lg_u32 s68, 0
    s_cbranch_scc1 L_ld_v

    s_mov_b32 m0, 131072
    s_lshl_b32 s66, s4, 17
    s_lshl_b32 s62, s5, 7
    s_add_u32 s66, s66, s62
    s_mov_b32 s68, 4
L_ld_wo:
    buffer_load_dwordx4 v16, s[44:47], s66 offen nt lds
    s_add_u32 m0, m0, 1024
    s_add_u32 s66, s66, 8192
    s_waitcnt vmcnt(23)
    buffer_load_dwordx4 v17, s[44:47], s66 offen nt lds
    s_add_u32 m0, m0, 1024
    s_add_u32 s66, s66, 8192
    s_waitcnt vmcnt(23)
    buffer_load_dwordx4 v16, s[44:47], s66 offen nt lds
    s_add_u32 m0, m0, 1024
    s_add_u32 s66, s66, 8192
    s_waitcnt vmcnt(23)
    buffer_load_dwordx4 v17, s[44:47], s66 offen nt lds
    s_add_u32 m0, m0, 1024
    s_add_u32 s66, s66, 8192
    s_waitcnt vmcnt(23)
    s_add_i32 s69, s69, 4
    s_max_i32 s100, s69, s100
    v_mov_b32 v27, s100
    s_mov_b64 exec, 1
    ds_write_b32 v26, v27 offset:0
    s_mov_b64 exec, -1
    s_sub_u32 s68, s68, 1
    s_cmp_lg_u32 s68, 0
    s_cbranch_scc1 L_ld_wo

    s_mov_b32 m0, 147456
    s_lshl_b32 s66, s60, 13
    s_lshl_b32 s62, s5, 7
    s_add_u32 s66, s66, s62
    s_mov_b32 s68, 0x7fff0000
    s_cmp_lt_u32 0, s70
    s_cselect_b32 s62, s66, s68
    buffer_load_dwordx4 v16, s[56:59], s62 offen nt lds
    s_add_u32 m0, m0, 1024
    s_add_u32 s66, s66, 8192
    s_waitcnt vmcnt(23)
    s_cmp_lt_u32 1, s70
    s_cselect_b32 s62, s66, s68
    buffer_load_dwordx4 v17, s[56:59], s62 offen nt lds
    s_add_u32 m0, m0, 1024
    s_add_u32 s66, s66, 8192
    s_waitcnt vmcnt(23)
    s_add_i32 s69, s69, 2
    s_max_i32 s100, s69, s100
    v_mov_b32 v27, s100
    s_mov_b64 exec, 1
    ds_write_b32 v26, v27 offset:0
    s_mov_b64 exec, -1

    s_cmp_lt_u32 2, s70
    s_cselect_b32 s62, s66, s68
    buffer_load_dwordx4 v16, s[56:59], s62 offen nt lds
    s_add_u32 m0, m0, 1024
    s_add_u32 s66, s66, 8192
    s_waitcnt vmcnt(23)
    s_cmp_lt_u32 3, s70
    s_cselect_b32 s62, s66, s68
    buffer_load_dwordx4 v17, s[56:59], s62 offen nt lds
    s_add_u32 m0, m0, 1024
    s_add_u32 s66, s66, 8192
    s_waitcnt vmcnt(23)
    s_add_i32 s69, s69, 2
    s_max_i32 s100, s69, s100
    v_mov_b32 v27, s100
    s_mov_b64 exec, 1
    ds_write_b32 v26, v27 offset:0
    s_mov_b64 exec, -1

    s_cmp_lt_u32 4, s70
    s_cselect_b32 s62, s66, s68
    buffer_load_dwordx4 v16, s[56:59], s62 offen nt lds
    s_add_u32 m0, m0, 1024
    s_add_u32 s66, s66, 8192
    s_waitcnt vmcnt(23)
    s_cmp_lt_u32 5, s70
    s_cselect_b32 s62, s66, s68
    buffer_load_dwordx4 v17, s[56:59], s62 offen nt lds
    s_add_u32 m0, m0, 1024
    s_add_u32 s66, s66, 8192
    s_waitcnt vmcnt(23)
    s_add_i32 s69, s69, 2
    s_max_i32 s100, s69, s100
    v_mov_b32 v27, s100
    s_mov_b64 exec, 1
    ds_write_b32 v26, v27 offset:0
    s_mov_b64 exec, -1

    s_cmp_lt_u32 6, s70
    s_cselect_b32 s62, s66, s68
    buffer_load_dwordx4 v16, s[56:59], s62 offen nt lds
    s_add_u32 m0, m0, 1024
    s_add_u32 s66, s66, 8192
    s_waitcnt vmcnt(23)
    s_cmp_lt_u32 7, s70
    s_cselect_b32 s62, s66, s68
    buffer_load_dwordx4 v17, s[56:59], s62 offen nt lds
    s_add_u32 m0, m0, 1024
    s_add_u32 s66, s66, 8192
    s_waitcnt vmcnt(24)
    s_barrier
    s_waitcnt vmcnt(0)
    s_barrier
    s_waitcnt lgkmcnt(0)
    s_endpgm
L_compute:
    v_mov_b32 v1, v0
    s_sub_u32 s66, s3, 1
    s_lshr_b32 s67, s5, 2
    s_load_dword s7, s[30:31], 0
    v_and_b32 v2, 15, v1
    v_lshrrev_b32 v3, 4, v1
    v_and_b32 v12, 1, v2
    v_lshlrev_b32 v12, 10, v12
    v_lshl_add_u32 v12, v3, 4, v12
    s_lshl_b32 s62, s5, 7
    v_add_u32 v12, s62, v12
    v_lshlrev_b32 v13, 4, v1
    global_load_dwordx4 v[32:35], v12, s[8:9]
    global_load_dwordx4 v[36:39], v12, s[8:9] offset:64
    s_mov_b32 s68, 0
    v_lshrrev_b32 v4, 2, v2
    v_and_b32 v5, 3, v2
    v_mov_b32 v6, 0xff
    v_mov_b32 v7, 155648
    v_mov_b32 v8, 1
    s_cmp_lg_u32 s66, 3
    s_cbranch_scc1 L_nopf
    global_load_dwordx4 v[44:47], v13, s[8:9]
    global_load_dwordx4 v[48:51], v13, s[8:9] offset:1024
    global_load_dwordx4 v[52:55], v13, s[26:27]

    s_getpc_b64 s[64:65]
        L_pc:
    s_lshr_b32 s62, s2, 3
    s_and_b32 s62, s62, 15
    s_lshl_b32 s62, s62, 10
    s_sub_u32 s64, s64, L_pc-gated_mix__sliding_block_cached__glu_gated_reglu__decode_kernel
    s_subb_u32 s65, s65, 0
    s_min_u32 s62, s62, L_codeend-gated_mix__sliding_block_cached__glu_gated_reglu__decode_kernel-1024
    s_add_u32 s64, s64, s62
    s_addc_u32 s65, s65, 0
    global_load_dwordx4 v[40:43], v13, s[64:65]

L_nopf:
    s_mov_b32 s32, s30
    s_mov_b32 s33, s31
    s_mov_b32 s34, 4194304
    s_mov_b32 s35, 0x20000
    s_lshl_b32 s62, s4, 3
    s_add_u32 s62, s62, s5
    s_mul_i32 s36, s62, 2048
    s_add_u32 s36, s36, 65536
    s_mul_i32 s37, s62, 640
    s_add_u32 s37, s37, 1048576
    s_lshl_b32 s38, s5, 14
    s_lshl_b32 s62, s4, 9
    s_add_u32 s38, s38, s62
    s_add_u32 s38, s38, 1310720
    v_lshl_add_u32 v12, v3, 3, v4
    v_and_b32 v13, 1, v3
    v_lshl_or_b32 v14, v13, 2, v4
    v_lshlrev_b32 v15, 8, v12
    v_lshl_add_u32 v15, v5, 3, v15
    v_add_u32 v15, 65536, v15
    s_lshl_b32 s62, s66, 1
    v_xor_b32 v9, s62, v14
    v_lshl_add_u32 v9, v9, 5, v15
    s_add_u32 s62, s62, 1
    v_xor_b32 v10, s62, v14
    v_lshl_add_u32 v10, v10, 5, v15
    v_lshrrev_b32 v14, 1, v4
    v_lshl_or_b32 v15, v13, 1, v14
    v_xor_b32 v15, s66, v15
    v_lshlrev_b32 v15, 5, v15
    v_lshl_add_u32 v15, v12, 7, v15
    v_lshl_add_u32 v15, v5, 3, v15
    v_add_u32 v11, 114688, v15
    v_add_u32 v24, 131072, v15
    s_lshl_b32 s62, s66, 14
    v_lshlrev_b32 v12, 8, v2
    v_add_u32 v12, s62, v12
    v_xor_b32 v13, v3, v2

    v_xor_b32 v14, 0, v13
    v_lshl_add_u32 v25, v14, 4, v12
    v_xor_b32 v14, 4, v13
    v_lshl_add_u32 v26, v14, 4, v12
    v_xor_b32 v14, 8, v13
    v_lshl_add_u32 v27, v14, 4, v12
    v_xor_b32 v14, 12, v13
    v_lshl_add_u32 v28, v14, 4, v12
    v_lshlrev_b32 v30, 6, v2
    v_lshl_add_u32 v30, v3, 4, v30

    s_cmp_ge_u32 s68, 16
    s_cbranch_scc1 L_w16_ok
        L_w16:
    ds_read_b32 v19, v7 offset:0
    s_waitcnt lgkmcnt(0)
    v_readfirstlane_b32 s68, v19
    s_cmp_ge_u32 s68, 16
    s_cbranch_scc1 L_w16_ok

    s_sub_u32 s61, s61, 1
    s_cbranch_scc1 L_exit
    s_sleep 3
    s_branch L_w16

L_w16_ok:
    ds_read_b64_tr_b16 v[56:57], v9 offset:32768
    ds_read_b64_tr_b16 v[58:59], v9 offset:33792
    ds_read_b64_tr_b16 v[60:61], v9 offset:40960
    ds_read_b64_tr_b16 v[62:63], v9 offset:41984
    ds_read_b64_tr_b16 v[64:65], v10 offset:32768
    ds_read_b64_tr_b16 v[66:67], v10 offset:33792
    ds_read_b64_tr_b16 v[68:69], v10 offset:40960
    ds_read_b64_tr_b16 v[70:71], v10 offset:41984
    s_add_u32 s7, s7, 1
    s_and_b32 s6, s7, 0xff
    s_waitcnt vmcnt(0) lgkmcnt(0)

    v_mfma_f32_16x16x32_bf16 v[72:75], v[56:59], v[32:35], 0
    v_mfma_f32_16x16x32_bf16 v[76:79], v[64:67], v[32:35], 0
    v_mfma_f32_16x16x32_bf16 v[72:75], v[60:63], v[36:39], v[72:75]
    v_mfma_f32_16x16x32_bf16 v[76:79], v[68:71], v[36:39], v[76:79]
    s_lshl_b32 s62, s66, 8
    s_add_u32 s62, s62, s36
    s_nop 6

    v_bfi_b32 v72, v6, s6, v72
    v_bfi_b32 v73, v6, s6, v73
    v_bfi_b32 v74, v6, s6, v74
    v_bfi_b32 v75, v6, s6, v75
    v_bfi_b32 v76, v6, s6, v76
    v_bfi_b32 v77, v6, s6, v77
    v_bfi_b32 v78, v6, s6, v78
    v_bfi_b32 v79, v6, s6, v79
    s_mov_b32 exec_lo, 0x00030003
    s_mov_b32 exec_hi, 0x00030003
    s_add_u32 s63, s62, 2555904
    buffer_store_dwordx4 v[72:75], v30, s[32:35], s63 offen
    buffer_store_dwordx4 v[76:79], v30, s[32:35], s63 offen offset:128
    s_getreg_b32 s101, hwreg(HW_REG_XCC_ID)
    s_add_u32 s100, s7, 0x5bd1e995
    s_cmp_lg_u32 s66, 0
    s_cbranch_scc1 L_noid
    s_lshl_b32 s63, s4, 7
    s_lshl_b32 s64, s5, 3
    s_add_u32 s63, s63, s64
    s_add_u32 s63, s63, 32768
    v_mov_b32 v14, s100
    v_mov_b32 v15, s101
    v_mov_b32 v12, 0
    s_mov_b64 exec, 1
    buffer_store_dwordx2 v[14:15], v12, s[32:35], s63 offen
    L_noid:
    s_mov_b64 exec, -1

    s_cmp_eq_u32 s66, 3
    s_cbranch_scc1 L_gate

    s_cmp_ge_u32 s68, 32
    s_cbranch_scc1 L_w32_ok
        L_w32:
    ds_read_b32 v19, v7 offset:0
    s_waitcnt lgkmcnt(0)
    v_readfirstlane_b32 s68, v19
    s_cmp_ge_u32 s68, 32
    s_cbranch_scc1 L_w32_ok

    s_sub_u32 s61, s61, 1
    s_cbranch_scc1 L_exit
    s_sleep 3
    s_branch L_w32

L_w32_ok:
    ds_read_b64_tr_b16 v[56:57], v11 offset:0
    ds_read_b64_tr_b16 v[58:59], v11 offset:512
    ds_read_b64_tr_b16 v[60:61], v11 offset:4096
    ds_read_b64_tr_b16 v[62:63], v11 offset:4608
    ds_read_b64_tr_b16 v[64:65], v11 offset:8192
    ds_read_b64_tr_b16 v[66:67], v11 offset:8704
    ds_read_b64_tr_b16 v[68:69], v11 offset:12288
    ds_read_b64_tr_b16 v[70:71], v11 offset:12800
    s_waitcnt lgkmcnt(0)
    v_mfma_f32_16x16x32_bf16 v[80:83], v[56:59], v[32:35], 0
    v_mfma_f32_16x16x32_bf16 v[84:87], v[64:67], v[32:35], 0
    v_mfma_f32_16x16x32_bf16 v[80:83], v[60:63], v[36:39], v[80:83]
    v_mfma_f32_16x16x32_bf16 v[84:87], v[68:71], v[36:39], v[84:87]
    s_mov_b64 exec, 1
    ds_add_u32 v7, v8 offset:4
    s_mov_b64 exec, -1

    s_lshl_b32 s62, s66, 7
    s_add_u32 s62, s62, s36
    s_nop 5

    v_bfi_b32 v80, v6, s6, v80
    v_bfi_b32 v81, v6, s6, v81
    v_bfi_b32 v82, v6, s6, v82
    v_bfi_b32 v83, v6, s6, v83
    v_bfi_b32 v84, v6, s6, v84
    v_bfi_b32 v85, v6, s6, v85
    v_bfi_b32 v86, v6, s6, v86
    v_bfi_b32 v87, v6, s6, v87
    s_mov_b32 exec_lo, 0x00030003
    s_mov_b32 exec_hi, 0x00030003
    s_add_u32 s63, s62, 2555904
    buffer_store_dwordx4 v[80:83], v30, s[32:35], s63 offen offset:1024
    buffer_store_dwordx4 v[84:87], v30, s[32:35], s63 offen offset:1536
    s_mov_b64 exec, -1
    s_branch L_p3
L_gate:
    s_mov_b64 exec, 1
    ds_add_u32 v7, v8 offset:4
    s_mov_b64 exec, -1

    v_mov_b32 v14, 0
    v_mov_b32 v15, 0
    v_lshlrev_b32 v16, 16, v52
    v_and_b32 v17, 0xffff0000, v52
    v_lshlrev_b32 v18, 16, v44
    v_fmac_f32 v14, v18, v16
    v_and_b32 v18, 0xffff0000, v44
    v_fmac_f32 v14, v18, v17
    v_lshlrev_b32 v18, 16, v48
    v_fmac_f32 v15, v18, v16
    v_and_b32 v18, 0xffff0000, v48
    v_fmac_f32 v15, v18, v17
    v_lshlrev_b32 v16, 16, v53
    v_and_b32 v17, 0xffff0000, v53
    v_lshlrev_b32 v18, 16, v45
    v_fmac_f32 v14, v18, v16
    v_and_b32 v18, 0xffff0000, v45
    v_fmac_f32 v14, v18, v17
    v_lshlrev_b32 v18, 16, v49
    v_fmac_f32 v15, v18, v16
    v_and_b32 v18, 0xffff0000, v49
    v_fmac_f32 v15, v18, v17
    v_lshlrev_b32 v16, 16, v54
    v_and_b32 v17, 0xffff0000, v54
    v_lshlrev_b32 v18, 16, v46
    v_fmac_f32 v14, v18, v16
    v_and_b32 v18, 0xffff0000, v46
    v_fmac_f32 v14, v18, v17
    v_lshlrev_b32 v18, 16, v50
    v_fmac_f32 v15, v18, v16
    v_and_b32 v18, 0xffff0000, v50
    v_fmac_f32 v15, v18, v17
    v_lshlrev_b32 v16, 16, v55
    v_and_b32 v17, 0xffff0000, v55
    v_lshlrev_b32 v18, 16, v47
    v_fmac_f32 v14, v18, v16
    v_and_b32 v18, 0xffff0000, v47
    v_fmac_f32 v14, v18, v17
    v_lshlrev_b32 v18, 16, v51
    v_fmac_f32 v15, v18, v16
    v_and_b32 v18, 0xffff0000, v51
    v_fmac_f32 v15, v18, v17
    s_nop 1
    v_add_f32_dpp v14, v14, v14 row_ror:8 row_mask:0xf bank_mask:0xf
    v_add_f32_dpp v15, v15, v15 row_ror:8 row_mask:0xf bank_mask:0xf
    s_nop 1
    v_add_f32_dpp v14, v14, v14 row_ror:4 row_mask:0xf bank_mask:0xf
    v_add_f32_dpp v15, v15, v15 row_ror:4 row_mask:0xf bank_mask:0xf
    s_nop 1
    v_add_f32_dpp v14, v14, v14 row_ror:2 row_mask:0xf bank_mask:0xf
    v_add_f32_dpp v15, v15, v15 row_ror:2 row_mask:0xf bank_mask:0xf
    s_nop 1
    v_add_f32_dpp v14, v14, v14 row_ror:1 row_mask:0xf bank_mask:0xf
    v_add_f32_dpp v15, v15, v15 row_ror:1 row_mask:0xf bank_mask:0xf
    v_mov_b32 v20, v14
    v_mov_b32 v21, v15
    s_nop 0
    v_permlane16_swap_b32 v20, v14
    v_permlane16_swap_b32 v21, v15
    v_add_f32 v14, v20, v14
    v_add_f32 v15, v21, v15
    v_mov_b32 v20, v14
    v_mov_b32 v21, v15
    s_nop 0
    v_permlane32_swap_b32 v20, v14
    v_permlane32_swap_b32 v21, v15
    v_add_f32 v14, v20, v14
    v_add_f32 v15, v21, v15
    v_mul_f32 v14, 0xbfb8aa3b, v14
    v_mul_f32 v15, 0xbfb8aa3b, v15
    v_exp_f32 v14, v14
    v_exp_f32 v15, v15
    s_nop 0
    v_add_f32 v14, 1.0, v14
    v_add_f32 v15, 1.0, v15
    v_rcp_f32 v14, v14
    v_rcp_f32 v15, v15
    s_nop 0
    s_mov_b64 exec, 1
    ds_write_b64 v7, v[14:15] offset:48
    s_mov_b64 exec, -1

L_p3:
    s_cmp_lg_u32 s66, 0
    s_cbranch_scc1 L_waitm
    s_mul_i32 s62, s4, 16384
    s_lshl_b32 s63, s67, 6
    s_add_u32 s62, s62, s63
    s_add_u32 s62, s62, 65536
    v_lshrrev_b32 v13, 5, v1
    v_lshlrev_b32 v13, 11, v13
    v_and_b32 v14, 31, v1
    v_lshrrev_b32 v16, 2, v14
    v_lshl_add_u32 v13, v16, 7, v13
    v_and_b32 v16, 3, v14
    v_lshl_add_u32 v13, v16, 4, v13
    v_and_b32 v15, 7, v1
    v_lshlrev_b32 v15, 3, v15
    s_lshl_b32 s42, s4, 7
    s_add_u32 s41, s42, 36864
    s_add_u32 s42, s42, 32768
    s_mov_b32 s43, 3
    s_mov_b32 s46, 0

    s_cmp_ge_u32 s68, 48
    s_cbranch_scc1 L_wqd_ok
        L_wqd:
    ds_read_b32 v19, v7 offset:0
    s_waitcnt lgkmcnt(0)
    v_readfirstlane_b32 s68, v19
    s_cmp_ge_u32 s68, 48
    s_cbranch_scc1 L_wqd_ok

    s_sub_u32 s61, s61, 1
    s_cbranch_scc1 L_exit
    s_sleep 3
    s_branch L_wqd

L_wqd_ok:
L_ql:
    buffer_load_dwordx2 v[44:45], v15, s[32:35], s42 offen sc1
    s_add_u32 s63, s62, 2555904
    buffer_load_dwordx4 v[88:91], v13, s[32:35], s63 offen sc1
    s_add_u32 s63, s63, 4096
    buffer_load_dwordx4 v[92:95], v13, s[32:35], s63 offen sc1
    s_add_u32 s63, s63, 4096
    buffer_load_dwordx4 v[96:99], v13, s[32:35], s63 offen sc1
    s_add_u32 s63, s63, 4096
    buffer_load_dwordx4 v[100:103], v13, s[32:35], s63 offen sc1
    s_waitcnt vmcnt(0)
    v_xor_b32 v88, s6, v88
    v_xor_b32 v89, s6, v89
    v_xor_b32 v90, s6, v90
    v_xor_b32 v91, s6, v91
    v_xor_b32 v92, s6, v92
    v_xor_b32 v93, s6, v93
    v_xor_b32 v94, s6, v94
    v_xor_b32 v95, s6, v95
    v_xor_b32 v96, s6, v96
    v_xor_b32 v97, s6, v97
    v_xor_b32 v98, s6, v98
    v_xor_b32 v99, s6, v99
    v_xor_b32 v100, s6, v100
    v_xor_b32 v101, s6, v101
    v_xor_b32 v102, s6, v102
    v_xor_b32 v103, s6, v103
    v_or_b32 v29, v88, v89
    v_or3_b32 v29, v29, v90, v91
    v_or3_b32 v29, v29, v92, v93
    v_or3_b32 v29, v29, v94, v95
    v_or3_b32 v29, v29, v96, v97
    v_or3_b32 v29, v29, v98, v99
    v_or3_b32 v29, v29, v100, v101
    v_or3_b32 v29, v29, v102, v103
    v_and_b32 v29, v6, v29
    v_cmp_ne_u32 vcc, 0, v29
    s_mov_b64 s[44:45], vcc
    v_cmp_ne_u32 vcc, s100, v44
    s_or_b64 s[44:45], s[44:45], vcc
    s_cmp_eq_u64 s[44:45], 0
    s_cbranch_scc1 L_have

    s_cmp_lg_u32 s46, 0
    s_cbranch_scc1 L_tryg
    s_sub_u32 s43, s43, 1
    s_cmp_lg_u32 s43, 0
    s_cbranch_scc1 L_ql

    s_mov_b64 exec, 1
    ds_write_b32 v7, v8 offset:56
    s_mov_b64 exec, -1

    s_lshl_b32 s63, s66, 8
    s_add_u32 s63, s63, s36
    s_lshl_b32 s64, s66, 7
    s_add_u32 s64, s64, s36

    s_mov_b32 exec_lo, 0x00030003
    s_mov_b32 exec_hi, 0x00030003
    buffer_store_dwordx4 v[72:75], v30, s[32:35], s63 offen sc1
    buffer_store_dwordx4 v[76:79], v30, s[32:35], s63 offen offset:128 sc1
    s_cmp_eq_u32 s66, 3
    s_cbranch_scc1 L_gs_1
    buffer_store_dwordx4 v[80:83], v30, s[32:35], s64 offen offset:1024 sc1
    buffer_store_dwordx4 v[84:87], v30, s[32:35], s64 offen offset:1536 sc1
        L_gs_1:
    s_mov_b64 exec, -1

    s_lshl_b32 s63, s4, 7
    s_lshl_b32 s64, s5, 3
    s_add_u32 s63, s63, s64
    s_add_u32 s63, s63, 36864
    v_mov_b32 v44, s100
    v_mov_b32 v45, s101
    v_mov_b32 v16, 0
    s_mov_b64 exec, 1
    buffer_store_dwordx2 v[44:45], v16, s[32:35], s63 offen sc1
    s_mov_b64 exec, -1
    s_mov_b32 s46, 1

L_tryg:
    buffer_load_dwordx2 v[44:45], v15, s[32:35], s41 offen sc1
    s_add_u32 s63, s62, 0
    buffer_load_dwordx4 v[88:91], v13, s[32:35], s63 offen sc1
    s_add_u32 s63, s63, 4096
    buffer_load_dwordx4 v[92:95], v13, s[32:35], s63 offen sc1
    s_add_u32 s63, s63, 4096
    buffer_load_dwordx4 v[96:99], v13, s[32:35], s63 offen sc1
    s_add_u32 s63, s63, 4096
    buffer_load_dwordx4 v[100:103], v13, s[32:35], s63 offen sc1
    s_waitcnt vmcnt(0)
    v_xor_b32 v88, s6, v88
    v_xor_b32 v89, s6, v89
    v_xor_b32 v90, s6, v90
    v_xor_b32 v91, s6, v91
    v_xor_b32 v92, s6, v92
    v_xor_b32 v93, s6, v93
    v_xor_b32 v94, s6, v94
    v_xor_b32 v95, s6, v95
    v_xor_b32 v96, s6, v96
    v_xor_b32 v97, s6, v97
    v_xor_b32 v98, s6, v98
    v_xor_b32 v99, s6, v99
    v_xor_b32 v100, s6, v100
    v_xor_b32 v101, s6, v101
    v_xor_b32 v102, s6, v102
    v_xor_b32 v103, s6, v103
    v_or_b32 v29, v88, v89
    v_or3_b32 v29, v29, v90, v91
    v_or3_b32 v29, v29, v92, v93
    v_or3_b32 v29, v29, v94, v95
    v_or3_b32 v29, v29, v96, v97
    v_or3_b32 v29, v29, v98, v99
    v_or3_b32 v29, v29, v100, v101
    v_or3_b32 v29, v29, v102, v103
    v_and_b32 v29, v6, v29
    v_cmp_ne_u32 vcc, 0, v29
    s_mov_b64 s[44:45], vcc
    v_cmp_ne_u32 vcc, s100, v44
    s_or_b64 s[44:45], s[44:45], vcc
    s_cmp_eq_u64 s[44:45], 0
    s_cbranch_scc1 L_have

    s_sub_u32 s61, s61, 1
    s_cbranch_scc1 L_exit
    s_branch L_ql
    L_have:
    v_cmp_ne_u32 vcc, s101, v45
    s_mov_b32 s47, 1
    s_cbranch_vccz L_idsame
    s_mov_b32 s47, 2
    L_idsame:

    s_cmp_eq_u32 s47, 1
    s_cbranch_scc1 L_setmode
    s_cmp_lg_u32 s46, 0
    s_cbranch_scc1 L_setmode

    s_mov_b64 exec, 1
    ds_write_b32 v7, v8 offset:56
    s_mov_b64 exec, -1

    s_lshl_b32 s63, s66, 8
    s_add_u32 s63, s63, s36
    s_lshl_b32 s64, s66, 7
    s_add_u32 s64, s64, s36

    s_mov_b32 exec_lo, 0x00030003
    s_mov_b32 exec_hi, 0x00030003
    buffer_store_dwordx4 v[72:75], v30, s[32:35], s63 offen sc1
    buffer_store_dwordx4 v[76:79], v30, s[32:35], s63 offen offset:128 sc1
    s_cmp_eq_u32 s66, 3
    s_cbranch_scc1 L_gs_2
    buffer_store_dwordx4 v[80:83], v30, s[32:35], s64 offen offset:1024 sc1
    buffer_store_dwordx4 v[84:87], v30, s[32:35], s64 offen offset:1536 sc1
        L_gs_2:
    s_mov_b64 exec, -1

    s_lshl_b32 s63, s4, 7
    s_lshl_b32 s64, s5, 3
    s_add_u32 s63, s63, s64
    s_add_u32 s63, s63, 36864
    v_mov_b32 v44, s100
    v_mov_b32 v45, s101
    v_mov_b32 v16, 0
    s_mov_b64 exec, 1
    buffer_store_dwordx2 v[44:45], v16, s[32:35], s63 offen sc1
    s_mov_b64 exec, -1
    s_mov_b32 s46, 1

    L_setmode:
    v_mov_b32 v16, s47
    s_mov_b64 exec, 1
    ds_write_b32 v7, v16 offset:60
    s_mov_b64 exec, -1

    v_add_f32 v88, v88, v92
    v_add_f32 v96, v96, v100
    v_add_f32 v89, v89, v93
    v_add_f32 v97, v97, v101
    v_add_f32 v90, v90, v94
    v_add_f32 v98, v98, v102
    v_add_f32 v91, v91, v95
    v_add_f32 v99, v99, v103
    v_add_f32 v88, v88, v96
    v_add_f32 v89, v89, v97
    v_add_f32 v90, v90, v98
    v_add_f32 v91, v91, v99
    v_mov_b32 v92, v88
    v_mov_b32 v93, v89
    v_mov_b32 v94, v90
    v_mov_b32 v95, v91
    v_permlane32_swap_b32 v92, v88
    v_permlane32_swap_b32 v93, v89
    v_permlane32_swap_b32 v94, v90
    v_permlane32_swap_b32 v95, v91
    v_add_f32 v88, v88, v92
    v_add_f32 v89, v89, v93
    v_add_f32 v90, v90, v94
    v_add_f32 v91, v91, v95
    v_cvt_pk_bf16_f32 v92, v88, v89
    v_cvt_pk_bf16_f32 v93, v90, v91
    v_lshl_add_u32 v14, v14, 3, v7
    s_mov_b32 exec_hi, 0
    ds_write_b64 v14, v[92:93] offset:64
    s_mov_b64 exec, 1
    ds_write_b32 v7, v8 offset:12
    s_mov_b64 exec, -1

    s_branch L_waitq
    L_waitm:
    s_mov_b32 s46, 0
    L_wm:
    ds_read_b32 v18, v7 offset:12
    ds_read_b32 v19, v7 offset:56
    s_waitcnt lgkmcnt(0)
    v_readfirstlane_b32 s47, v18
    v_readfirstlane_b32 s62, v19
    s_andn2_b32 s62, s62, s46
    s_cbranch_scc0 L_wm_nog

    s_lshl_b32 s63, s66, 8
    s_add_u32 s63, s63, s36
    s_lshl_b32 s64, s66, 7
    s_add_u32 s64, s64, s36

    s_mov_b32 exec_lo, 0x00030003
    s_mov_b32 exec_hi, 0x00030003
    buffer_store_dwordx4 v[72:75], v30, s[32:35], s63 offen sc1
    buffer_store_dwordx4 v[76:79], v30, s[32:35], s63 offen offset:128 sc1
    s_cmp_eq_u32 s66, 3
    s_cbranch_scc1 L_gs_3
    buffer_store_dwordx4 v[80:83], v30, s[32:35], s64 offen offset:1024 sc1
    buffer_store_dwordx4 v[84:87], v30, s[32:35], s64 offen offset:1536 sc1
        L_gs_3:
    s_mov_b64 exec, -1

    s_mov_b32 s46, 1
    L_wm_nog:
    s_cmp_lg_u32 s47, 0
    s_cbranch_scc1 L_qrdy

    s_sub_u32 s61, s61, 1
    s_cbranch_scc1 L_exit
    s_sleep 3
    s_branch L_wm

L_waitq:
L_qrdy:
    ds_read_b32 v19, v7 offset:60
    s_waitcnt lgkmcnt(0)
    v_readfirstlane_b32 s60, v19
    s_cmp_eq_u32 s60, 1
    s_cselect_b32 s69, 2555904, 0
    s_cselect_b32 s70, 524288, 0

    v_lshlrev_b32 v31, 11, v3
    v_lshl_add_u32 v31, v4, 7, v31
    v_lshl_add_u32 v31, v5, 4, v31
    s_sub_u32 s62, s66, 1
    s_and_b32 s63, s62, 1
    s_lshl_b32 s63, s63, 6
    s_mul_i32 s39, s4, 16384
    s_add_u32 s39, s39, s63
    s_add_u32 s39, s39, 66560
    s_add_u32 s39, s39, s69
    s_cmp_gt_u32 s62, 1
    s_cbranch_scc1 L_noffn1

    v_cmp_gt_u32 vcc, 12, v2
    s_and_b64 exec, exec, vcc
    s_add_u32 s63, s39, 8192
    buffer_load_dwordx4 v[104:107], v31, s[32:35], s39 offen sc1
    buffer_load_dwordx4 v[108:111], v31, s[32:35], s63 offen sc1
    buffer_load_dwordx4 v[112:115], v31, s[32:35], s39 offen offset:512 sc1
    buffer_load_dwordx4 v[116:119], v31, s[32:35], s63 offen offset:512 sc1
    s_mov_b64 exec, -1

L_noffn1:
    v_lshlrev_b32 v12, 4, v3
    v_add_u32 v12, v7, v12

    ds_read_b128 v[120:123], v12 offset:64
    ds_read_b128 v[124:127], v12 offset:128
    ds_read_b128 v[128:131], v12 offset:192
    ds_read_b128 v[132:135], v12 offset:256
    s_lshl_b32 s63, s66, 4
    s_add_u32 s63, s63, 48
    s_cmp_ge_u32 s68, s63
    s_cbranch_scc1 L_wk_ok
        L_wk:
    ds_read_b32 v19, v7 offset:0
    s_waitcnt lgkmcnt(0)
    v_readfirstlane_b32 s68, v19
    s_cmp_ge_u32 s68, s63
    s_cbranch_scc1 L_wk_ok

    s_sub_u32 s61, s61, 1
    s_cbranch_scc1 L_exit
    s_sleep 3
    s_branch L_wk

L_wk_ok:
    ds_read_b128 v[136:139], v25 offset:0
    ds_read_b128 v[140:143], v26 offset:0
    ds_read_b128 v[144:147], v27 offset:0
    ds_read_b128 v[148:151], v28 offset:0
    ds_read_b128 v[152:155], v25 offset:4096
    ds_read_b128 v[156:159], v26 offset:4096
    ds_read_b128 v[160:163], v27 offset:4096
    ds_read_b128 v[164:167], v28 offset:4096
    ds_read_b128 v[168:171], v25 offset:8192
    ds_read_b128 v[172:175], v26 offset:8192
    ds_read_b128 v[176:179], v27 offset:8192
    ds_read_b128 v[180:183], v28 offset:8192
    ds_read_b128 v[184:187], v25 offset:12288
    ds_read_b128 v[188:191], v26 offset:12288
    ds_read_b128 v[192:195], v27 offset:12288
    ds_read_b128 v[196:199], v28 offset:12288
    s_waitcnt lgkmcnt(12)
    v_mfma_f32_16x16x32_bf16 v[200:203], v[136:139], v[120:123], 0
    v_mfma_f32_16x16x32_bf16 v[200:203], v[140:143], v[124:127], v[200:203]
    v_mfma_f32_16x16x32_bf16 v[200:203], v[144:147], v[128:131], v[200:203]
    v_mfma_f32_16x16x32_bf16 v[200:203], v[148:151], v[132:135], v[200:203]
    s_waitcnt lgkmcnt(8)
    v_mfma_f32_16x16x32_bf16 v[204:207], v[152:155], v[120:123], 0
    v_mfma_f32_16x16x32_bf16 v[204:207], v[156:159], v[124:127], v[204:207]
    v_mfma_f32_16x16x32_bf16 v[204:207], v[160:163], v[128:131], v[204:207]
    v_mfma_f32_16x16x32_bf16 v[204:207], v[164:167], v[132:135], v[204:207]
    s_waitcnt lgkmcnt(4)
    v_mfma_f32_16x16x32_bf16 v[208:211], v[168:171], v[120:123], 0
    v_mfma_f32_16x16x32_bf16 v[208:211], v[172:175], v[124:127], v[208:211]
    v_mfma_f32_16x16x32_bf16 v[208:211], v[176:179], v[128:131], v[208:211]
    v_mfma_f32_16x16x32_bf16 v[208:211], v[180:183], v[132:135], v[208:211]
    s_waitcnt lgkmcnt(0)
    v_mfma_f32_16x16x32_bf16 v[212:215], v[184:187], v[120:123], 0
    v_mfma_f32_16x16x32_bf16 v[212:215], v[188:191], v[124:127], v[212:215]
    v_mfma_f32_16x16x32_bf16 v[212:215], v[192:195], v[128:131], v[212:215]
    v_mfma_f32_16x16x32_bf16 v[212:215], v[196:199], v[132:135], v[212:215]
    s_mov_b32 s63, 0x3e0293ee
    s_nop 3
    v_max3_f32 v46, v200, v201, v202

    v_max3_f32 v46, v46, v203, v204
    v_max3_f32 v46, v46, v205, v206
    v_max3_f32 v46, v46, v207, v208
    v_max3_f32 v46, v46, v209, v210
    v_max_f32 v46, v46, v211
    s_nop 1
    v_max3_f32 v46, v46, v212, v213
    v_max3_f32 v46, v46, v214, v215
    v_mov_b32 v20, v46
    s_nop 1
    v_permlane16_swap_b32 v20, v46
    v_max_f32 v46, v20, v46
    v_mov_b32 v20, v46
    s_nop 1
    v_permlane32_swap_b32 v20, v46
    v_max_f32 v46, v20, v46
    v_mul_f32 v46, s63, v46
    v_and_b32 v46, 0xffffff00, v46

    v_fma_f32 v200, v200, s63, -v46
    v_fma_f32 v201, v201, s63, -v46
    v_fma_f32 v202, v202, s63, -v46
    v_fma_f32 v203, v203, s63, -v46
    v_fma_f32 v204, v204, s63, -v46
    v_fma_f32 v205, v205, s63, -v46
    v_fma_f32 v206, v206, s63, -v46
    v_fma_f32 v207, v207, s63, -v46
    v_fma_f32 v208, v208, s63, -v46
    v_fma_f32 v209, v209, s63, -v46
    v_fma_f32 v210, v210, s63, -v46
    v_fma_f32 v211, v211, s63, -v46
    v_fma_f32 v212, v212, s63, -v46
    v_fma_f32 v213, v213, s63, -v46
    v_fma_f32 v214, v214, s63, -v46
    v_fma_f32 v215, v215, s63, -v46
    v_exp_f32 v200, v200
    v_exp_f32 v201, v201
    v_exp_f32 v202, v202
    v_exp_f32 v203, v203
    v_exp_f32 v204, v204
    v_exp_f32 v205, v205
    v_exp_f32 v206, v206
    v_exp_f32 v207, v207
    v_exp_f32 v208, v208
    v_exp_f32 v209, v209
    v_exp_f32 v210, v210
    v_exp_f32 v211, v211
    v_exp_f32 v212, v212
    v_exp_f32 v213, v213
    v_exp_f32 v214, v214
    v_exp_f32 v215, v215
    v_cvt_pk_bf16_f32 v136, v200, v201
    v_cvt_pk_bf16_f32 v137, v202, v203
    v_cvt_pk_bf16_f32 v138, v204, v205
    v_cvt_pk_bf16_f32 v139, v206, v207
    v_cvt_pk_bf16_f32 v140, v208, v209
    v_cvt_pk_bf16_f32 v141, v210, v211
    v_cvt_pk_bf16_f32 v142, v212, v213
    v_cvt_pk_bf16_f32 v143, v214, v215
    s_lshl_b32 s62, s66, 7
    v_lshl_add_u32 v13, v3, 3, v7
    v_add_u32 v13, s62, v13
    s_mov_b32 exec_lo, 0x00010001
    s_mov_b32 exec_hi, 0x00010001

    ds_write_b64 v13, v[136:137] offset:576
    ds_write_b64 v13, v[138:139] offset:608
    ds_write_b64 v13, v[140:141] offset:640
    ds_write_b64 v13, v[142:143] offset:672
    s_mov_b64 exec, -1
    v_add_f32 v200, v200, v201
    v_add_f32 v202, v202, v203
    v_add_f32 v204, v204, v205
    v_add_f32 v206, v206, v207
    v_add_f32 v208, v208, v209
    v_add_f32 v210, v210, v211
    v_add_f32 v212, v212, v213
    v_add_f32 v214, v214, v215
    v_add_f32 v200, v200, v202
    v_add_f32 v204, v204, v206
    v_add_f32 v208, v208, v210
    v_add_f32 v212, v212, v214
    v_add_f32 v200, v200, v204
    v_add_f32 v208, v208, v212
    v_add_f32 v47, v200, v208
    v_mov_b32 v20, v47
    s_nop 1
    v_permlane16_swap_b32 v20, v47
    v_add_f32 v47, v20, v47
    v_mov_b32 v20, v47
    s_nop 1
    v_permlane32_swap_b32 v20, v47
    v_add_f32 v47, v20, v47
    s_lshl_b32 s62, s66, 3
    v_add_u32 v12, s62, v7
    s_mov_b64 exec, 1
    ds_write_b64 v12, v[46:47] offset:16
    ds_add_u32 v7, v8 offset:8
    s_mov_b64 exec, -1

        L_bar1:
    ds_read_b32 v19, v7 offset:8
    s_waitcnt lgkmcnt(0)
    v_readfirstlane_b32 s62, v19
    s_cmp_ge_u32 s62, 4
    s_cbranch_scc1 L_bar1_ok

    s_sub_u32 s61, s61, 1
    s_cbranch_scc1 L_exit
    s_sleep 3
    s_branch L_bar1

L_bar1_ok:
    v_lshl_add_u32 v12, v3, 4, v7
    ds_read_b128 v[48:51], v7 offset:16
    ds_read_b128 v[52:55], v7 offset:32

    ds_read_b128 v[120:123], v12 offset:576
    ds_read_b128 v[124:127], v12 offset:640
    ds_read_b128 v[128:131], v12 offset:704
    ds_read_b128 v[132:135], v12 offset:768
    ds_read_b128 v[136:139], v12 offset:832
    ds_read_b128 v[140:143], v12 offset:896
    ds_read_b128 v[144:147], v12 offset:960
    ds_read_b128 v[148:151], v12 offset:1024
    s_waitcnt lgkmcnt(8)
    v_max3_f32 v16, v48, v50, v52
    v_max_f32 v16, v16, v54

    v_sub_f32 v48, v48, v16
    v_sub_f32 v50, v50, v16
    v_sub_f32 v52, v52, v16
    v_sub_f32 v54, v54, v16
    v_exp_f32 v48, v48
    v_exp_f32 v50, v50
    v_exp_f32 v52, v52
    v_exp_f32 v54, v54
    s_cmp_lg_u32 s66, 0
    s_cbranch_scc1 L_nostat
    v_mul_f32 v17, v48, v49
    v_fmac_f32 v17, v50, v51
    v_fmac_f32 v17, v52, v53
    v_fmac_f32 v17, v54, v55

    v_bfi_b32 v16, v6, s6, v16
    v_bfi_b32 v17, v6, s6, v17
    v_mov_b32 v18, v16
    v_mov_b32 v19, v17
    v_lshlrev_b32 v12, 4, v1
    s_mov_b64 exec, 0xff
    s_add_u32 s62, s37, 524288
    buffer_store_dwordx4 v[16:19], v12, s[32:35], s62 offen offset:512
    s_cmp_eq_u32 s60, 1
    s_cbranch_scc1 L_g3s
    buffer_store_dwordx4 v[16:19], v12, s[32:35], s37 offen offset:512 sc1
    L_g3s:
    s_mov_b64 exec, -1
    L_nostat:

    s_cmp_ge_u32 s68, 128
    s_cbranch_scc1 L_wvA_ok
        L_wvA:
    ds_read_b32 v19, v7 offset:0
    s_waitcnt lgkmcnt(0)
    v_readfirstlane_b32 s68, v19
    s_cmp_ge_u32 s68, 128
    s_cbranch_scc1 L_wvA_ok

    s_sub_u32 s61, s61, 1
    s_cbranch_scc1 L_exit
    s_sleep 3
    s_branch L_wvA

L_wvA_ok:
    ds_read_b64_tr_b16 v[184:185], v9 offset:0
    ds_read_b64_tr_b16 v[186:187], v9 offset:1024
    ds_read_b64_tr_b16 v[188:189], v10 offset:0
    ds_read_b64_tr_b16 v[190:191], v10 offset:1024
    ds_read_b64_tr_b16 v[192:193], v9 offset:8192
    ds_read_b64_tr_b16 v[194:195], v9 offset:9216
    ds_read_b64_tr_b16 v[196:197], v10 offset:8192
    ds_read_b64_tr_b16 v[198:199], v10 offset:9216
    ds_read_b64_tr_b16 v[200:201], v9 offset:16384
    ds_read_b64_tr_b16 v[202:203], v9 offset:17408
    ds_read_b64_tr_b16 v[204:205], v10 offset:16384
    ds_read_b64_tr_b16 v[206:207], v10 offset:17408
    ds_read_b64_tr_b16 v[208:209], v9 offset:24576
    ds_read_b64_tr_b16 v[210:211], v9 offset:25600
    ds_read_b64_tr_b16 v[212:213], v10 offset:24576
    ds_read_b64_tr_b16 v[214:215], v10 offset:25600
    s_waitcnt lgkmcnt(12)
    v_mfma_f32_16x16x32_bf16 v[152:155], v[184:187], v[120:123], 0
    v_mfma_f32_16x16x32_bf16 v[156:159], v[188:191], v[120:123], 0
    s_waitcnt lgkmcnt(8)
    v_mfma_f32_16x16x32_bf16 v[152:155], v[192:195], v[124:127], v[152:155]
    v_mfma_f32_16x16x32_bf16 v[156:159], v[196:199], v[124:127], v[156:159]
    s_waitcnt lgkmcnt(4)
    v_mfma_f32_16x16x32_bf16 v[160:163], v[200:203], v[128:131], 0
    v_mfma_f32_16x16x32_bf16 v[164:167], v[204:207], v[128:131], 0
    s_waitcnt lgkmcnt(0)
    v_mfma_f32_16x16x32_bf16 v[160:163], v[208:211], v[132:135], v[160:163]
    v_mfma_f32_16x16x32_bf16 v[164:167], v[212:215], v[132:135], v[164:167]
    v_and_b32 v12, 1, v2
    v_lshlrev_b32 v13, 6, v12
    v_lshl_add_u32 v216, v3, 4, v13
    s_lshr_b32 s63, s66, 1
    s_lshl_b32 s64, s4, 3
    s_lshl_b32 s65, s63, 2
    s_add_u32 s64, s64, s65
    s_mul_i32 s40, s64, 640
    s_add_u32 s40, s40, 1048576
    v_lshlrev_b32 v217, 2, v1
    v_and_b32 v218, 3, v1
    v_mul_u32_u24 v218, 640, v218

    s_add_u32 s40, s40, s70
    s_and_b32 s65, s66, 1
    s_lshl_b32 s65, s65, 8
    s_add_u32 s41, s40, s65
    s_add_u32 s41, s41, 0
    s_add_u32 s42, s41, 640
    s_add_u32 s43, s41, 1280
    s_add_u32 s44, s41, 1920

    s_sub_u32 s62, s66, 1
    s_cmp_gt_u32 s62, 1
    s_cbranch_scc1 L_noffn2
    s_waitcnt vmcnt(0)
    L_ffnchk:
    v_cmp_gt_u32 vcc, 12, v2
    s_and_b64 exec, exec, vcc

    v_xor_b32 v104, s6, v104
    v_xor_b32 v105, s6, v105
    v_xor_b32 v106, s6, v106
    v_xor_b32 v107, s6, v107
    v_xor_b32 v108, s6, v108
    v_xor_b32 v109, s6, v109
    v_xor_b32 v110, s6, v110
    v_xor_b32 v111, s6, v111
    v_xor_b32 v112, s6, v112
    v_xor_b32 v113, s6, v113
    v_xor_b32 v114, s6, v114
    v_xor_b32 v115, s6, v115
    v_xor_b32 v116, s6, v116
    v_xor_b32 v117, s6, v117
    v_xor_b32 v118, s6, v118
    v_xor_b32 v119, s6, v119
    v_or_b32 v29, v104, v105
    v_or3_b32 v29, v29, v106, v107
    v_or3_b32 v29, v29, v108, v109
    v_or3_b32 v29, v29, v110, v111
    v_or3_b32 v29, v29, v112, v113
    v_or3_b32 v29, v29, v114, v115
    v_or3_b32 v29, v29, v116, v117
    v_or3_b32 v29, v29, v118, v119
    v_and_b32 v29, v6, v29
    v_cmp_ne_u32 vcc, 0, v29
    s_mov_b64 exec, -1
    s_cbranch_vccz L_ffn_ok
    s_sub_u32 s61, s61, 1
    s_cbranch_scc1 L_exit

    v_cmp_gt_u32 vcc, 12, v2
    s_and_b64 exec, exec, vcc
    s_add_u32 s63, s39, 8192
    buffer_load_dwordx4 v[104:107], v31, s[32:35], s39 offen sc1
    buffer_load_dwordx4 v[108:111], v31, s[32:35], s63 offen sc1
    buffer_load_dwordx4 v[112:115], v31, s[32:35], s39 offen offset:512 sc1
    buffer_load_dwordx4 v[116:119], v31, s[32:35], s63 offen offset:512 sc1
    s_mov_b64 exec, -1

    s_waitcnt vmcnt(0)
    s_branch L_ffnchk
L_ffn_ok:
    v_add_f32 v104, v104, v108
    v_add_f32 v112, v112, v116
    v_add_f32 v105, v105, v109
    v_add_f32 v113, v113, v117
    v_add_f32 v106, v106, v110
    v_add_f32 v114, v114, v118
    v_add_f32 v107, v107, v111
    v_add_f32 v115, v115, v119
    v_mov_b32 v20, v104
    v_mov_b32 v21, v105
    v_mov_b32 v22, v106
    v_mov_b32 v23, v107
    v_permlane16_swap_b32 v20, v104
    v_permlane16_swap_b32 v21, v105
    v_permlane16_swap_b32 v22, v106
    v_permlane16_swap_b32 v23, v107
    v_add_f32 v104, v20, v104
    v_add_f32 v105, v21, v105
    v_add_f32 v106, v22, v106
    v_add_f32 v107, v23, v107
    v_mov_b32 v20, v112
    v_mov_b32 v21, v113
    v_mov_b32 v22, v114
    v_mov_b32 v23, v115
    v_permlane16_swap_b32 v20, v112
    v_permlane16_swap_b32 v21, v113
    v_permlane16_swap_b32 v22, v114
    v_permlane16_swap_b32 v23, v115
    v_add_f32 v112, v20, v112
    v_add_f32 v113, v21, v113
    v_add_f32 v114, v22, v114
    v_add_f32 v115, v23, v115
    v_mov_b32 v20, v104
    v_mov_b32 v21, v105
    v_mov_b32 v22, v106
    v_mov_b32 v23, v107
    v_permlane32_swap_b32 v20, v104
    v_permlane32_swap_b32 v21, v105
    v_permlane32_swap_b32 v22, v106
    v_permlane32_swap_b32 v23, v107
    v_add_f32 v104, v20, v104
    v_add_f32 v105, v21, v105
    v_add_f32 v106, v22, v106
    v_add_f32 v107, v23, v107
    v_mov_b32 v20, v112
    v_mov_b32 v21, v113
    v_mov_b32 v22, v114
    v_mov_b32 v23, v115
    v_permlane32_swap_b32 v20, v112
    v_permlane32_swap_b32 v21, v113
    v_permlane32_swap_b32 v22, v114
    v_permlane32_swap_b32 v23, v115
    v_add_f32 v112, v20, v112
    v_add_f32 v113, v21, v113
    v_add_f32 v114, v22, v114
    v_add_f32 v115, v23, v115
    v_cmp_gt_u32 vcc, 12, v2
    v_max_f32 v104, 0, v104
    v_mul_f32 v104, v104, v112
    v_cndmask_b32 v104, 0, v104, vcc
    v_max_f32 v105, 0, v105
    v_mul_f32 v105, v105, v113
    v_cndmask_b32 v105, 0, v105, vcc
    v_max_f32 v106, 0, v106
    v_mul_f32 v106, v106, v114
    v_cndmask_b32 v106, 0, v106, vcc
    v_max_f32 v107, 0, v107
    v_mul_f32 v107, v107, v115
    v_cndmask_b32 v107, 0, v107, vcc
    v_cvt_pk_bf16_f32 v108, v104, v105
    v_cvt_pk_bf16_f32 v109, v106, v107
    s_lshl_b32 s62, s62, 7
    v_lshl_add_u32 v13, v2, 3, v7
    v_add_u32 v13, s62, v13
    s_mov_b64 exec, 0xffff
    ds_write_b64 v13, v[108:109] offset:320
    s_mov_b64 exec, -1
    L_noffn2:

    s_cmp_ge_u32 s68, 144
    s_cbranch_scc1 L_wvB_ok
        L_wvB:
    ds_read_b32 v19, v7 offset:0
    s_waitcnt lgkmcnt(0)
    v_readfirstlane_b32 s68, v19
    s_cmp_ge_u32 s68, 144
    s_cbranch_scc1 L_wvB_ok

    s_sub_u32 s61, s61, 1
    s_cbranch_scc1 L_exit
    s_sleep 3
    s_branch L_wvB

L_wvB_ok:
    ds_read_b64_tr_b16 v[184:185], v9 offset:32768
    ds_read_b64_tr_b16 v[186:187], v9 offset:33792
    ds_read_b64_tr_b16 v[188:189], v10 offset:32768
    ds_read_b64_tr_b16 v[190:191], v10 offset:33792
    ds_read_b64_tr_b16 v[192:193], v9 offset:40960
    ds_read_b64_tr_b16 v[194:195], v9 offset:41984
    ds_read_b64_tr_b16 v[196:197], v10 offset:40960
    ds_read_b64_tr_b16 v[198:199], v10 offset:41984
    s_waitcnt lgkmcnt(4)
    v_mfma_f32_16x16x32_bf16 v[168:171], v[184:187], v[136:139], 0
    v_mfma_f32_16x16x32_bf16 v[172:175], v[188:191], v[136:139], 0
    s_waitcnt lgkmcnt(0)
    v_mfma_f32_16x16x32_bf16 v[168:171], v[192:195], v[140:143], v[168:171]
    v_mfma_f32_16x16x32_bf16 v[172:175], v[196:199], v[140:143], v[172:175]
    buffer_load_dwordx2 v[220:221], v218, s[32:35], s40 offen offset:512 sc1
    v_mul_f32 v152, v48, v152
    v_mul_f32 v153, v48, v153
    v_mul_f32 v154, v48, v154
    v_mul_f32 v155, v48, v155
    v_mul_f32 v156, v48, v156
    v_mul_f32 v157, v48, v157
    v_mul_f32 v158, v48, v158
    v_mul_f32 v159, v48, v159
    v_fmac_f32 v152, v50, v160
    v_fmac_f32 v153, v50, v161
    v_fmac_f32 v154, v50, v162
    v_fmac_f32 v155, v50, v163
    v_fmac_f32 v156, v50, v164
    v_fmac_f32 v157, v50, v165
    v_fmac_f32 v158, v50, v166
    v_fmac_f32 v159, v50, v167
    s_cmp_ge_u32 s68, 152
    s_cbranch_scc1 L_wvC_ok
        L_wvC:
    ds_read_b32 v19, v7 offset:0
    s_waitcnt lgkmcnt(0)
    v_readfirstlane_b32 s68, v19
    s_cmp_ge_u32 s68, 152
    s_cbranch_scc1 L_wvC_ok

    s_sub_u32 s61, s61, 1
    s_cbranch_scc1 L_exit

    s_branch L_wvC

L_wvC_ok:
    ds_read_b64_tr_b16 v[184:185], v9 offset:49152
    ds_read_b64_tr_b16 v[186:187], v9 offset:50176
    ds_read_b64_tr_b16 v[188:189], v10 offset:49152
    ds_read_b64_tr_b16 v[190:191], v10 offset:50176
    s_waitcnt lgkmcnt(0)
    v_mfma_f32_16x16x32_bf16 v[176:179], v[184:187], v[144:147], 0
    v_mfma_f32_16x16x32_bf16 v[180:183], v[188:191], v[144:147], 0
    v_fmac_f32 v152, v52, v168
    v_fmac_f32 v153, v52, v169
    v_fmac_f32 v154, v52, v170
    v_fmac_f32 v155, v52, v171
    v_fmac_f32 v156, v52, v172
    v_fmac_f32 v157, v52, v173
    v_fmac_f32 v158, v52, v174
    v_fmac_f32 v159, v52, v175
    v_cmp_eq_u32 vcc, 1, v12
    s_lshl_b32 s45, s66, 7
    s_add_u32 s45, s45, s37
    s_add_u32 s46, s45, 524288

    v_cndmask_b32 v152, v152, v156, vcc
    v_cndmask_b32 v153, v153, v157, vcc
    v_cndmask_b32 v154, v154, v158, vcc
    v_cndmask_b32 v155, v155, v159, vcc
    s_barrier
    ds_read_b64_tr_b16 v[184:185], v9 offset:57344
    ds_read_b64_tr_b16 v[186:187], v9 offset:58368
    ds_read_b64_tr_b16 v[188:189], v10 offset:57344
    ds_read_b64_tr_b16 v[190:191], v10 offset:58368
    s_waitcnt lgkmcnt(0)
    v_mfma_f32_16x16x32_bf16 v[176:179], v[184:187], v[148:151], v[176:179]
    v_mfma_f32_16x16x32_bf16 v[180:183], v[188:191], v[148:151], v[180:183]
    s_nop 7
    v_cndmask_b32 v176, v176, v180, vcc
    v_cndmask_b32 v177, v177, v181, vcc
    v_cndmask_b32 v178, v178, v182, vcc
    v_cndmask_b32 v179, v179, v183, vcc
    v_fmac_f32 v152, v54, v176
    v_fmac_f32 v153, v54, v177
    v_fmac_f32 v154, v54, v178
    v_fmac_f32 v155, v54, v179
    v_bfi_b32 v152, v6, s6, v152
    v_bfi_b32 v153, v6, s6, v153
    v_bfi_b32 v154, v6, s6, v154
    v_bfi_b32 v155, v6, s6, v155
    s_mov_b32 exec_lo, 0x00030003
    s_mov_b32 exec_hi, 0x00030003
    buffer_store_dwordx4 v[152:155], v216, s[32:35], s46 offen
    s_cmp_eq_u32 s60, 1
    s_cbranch_scc1 L_g3o
    buffer_store_dwordx4 v[152:155], v216, s[32:35], s45 offen sc1
L_g3o:
    s_mov_b64 exec, -1
    s_waitcnt vmcnt(1)
L_sg:
    v_xor_b32 v220, s6, v220
    v_xor_b32 v221, s6, v221
    v_or_b32 v29, v220, v221
    v_and_b32 v29, v6, v29
    v_cmp_ne_u32 vcc, 0, v29
    s_cbranch_vccz L_sg_ok
    s_sub_u32 s61, s61, 1
    s_cbranch_scc1 L_exit
    buffer_load_dwordx2 v[220:221], v218, s[32:35], s40 offen offset:512 sc1
    s_waitcnt vmcnt(0)
    s_branch L_sg
    L_sg_ok:
    v_mov_b32 v15, v220
    s_nop 1
    v_max_f32_dpp v15, v15, v15 quad_perm:[1,0,3,2] row_mask:0xf bank_mask:0xf
    s_nop 1
    v_max_f32_dpp v15, v15, v15 quad_perm:[2,3,0,1] row_mask:0xf bank_mask:0xf
    v_sub_f32 v15, v220, v15
    v_exp_f32 v15, v15
    s_nop 0
    v_mul_f32 v16, v15, v221
    s_nop 1
    v_add_f32_dpp v16, v16, v16 quad_perm:[1,0,3,2] row_mask:0xf bank_mask:0xf
    s_nop 1
    v_add_f32_dpp v16, v16, v16 quad_perm:[2,3,0,1] row_mask:0xf bank_mask:0xf
    v_rcp_f32 v16, v16
    s_nop 0
    v_mul_f32 v15, v15, v16
    s_nop 1

    v_mov_b32_dpp v224, v15 quad_perm:[0,0,0,0] row_mask:0xf bank_mask:0xf
    v_mov_b32_dpp v225, v15 quad_perm:[1,1,1,1] row_mask:0xf bank_mask:0xf
    v_mov_b32_dpp v226, v15 quad_perm:[2,2,2,2] row_mask:0xf bank_mask:0xf
    v_mov_b32_dpp v227, v15 quad_perm:[3,3,3,3] row_mask:0xf bank_mask:0xf
    v_and_b32 v12, 1, v2
    v_lshlrev_b32 v13, 7, v12
    v_add_u32 v13, v7, v13
    v_lshl_add_u32 v185, v3, 4, v13
    v_lshl_add_u32 v186, v12, 2, v7
    v_lshlrev_b32 v13, 8, v12
    v_lshl_add_u32 v13, v3, 4, v13
    v_add_u32 v187, v7, v13
    v_lshlrev_b32 v13, 6, v12
    v_lshl_add_u32 v189, v3, 4, v13
    s_lshl_b32 s62, s66, 7
    v_lshl_add_u32 v188, v1, 1, v7
    v_add_u32 v188, s62, v188
    s_lshl_b32 s48, s66, 7
    s_add_u32 s48, s48, s38

    s_lshl_b32 s62, s5, 14
    s_lshl_b32 s63, s66, 7
    s_add_u32 s62, s62, s63
    s_add_u32 s50, s62, 1310720
    s_add_u32 s51, s50, 4096
    s_add_u32 s52, s50, 8192
    s_add_u32 s53, s50, 12288
    v_lshrrev_b32 v190, 3, v1
    v_lshlrev_b32 v190, 9, v190
    v_and_b32 v191, 7, v1
    v_lshl_add_u32 v190, v191, 4, v190
    s_lshl_b32 s62, s5, 7
    s_lshl_b32 s63, s66, 5
    s_add_u32 s62, s62, s63
    v_lshrrev_b32 v15, 2, v191
    v_lshlrev_b32 v15, 10, v15
    v_and_b32 v191, 3, v191
    v_lshl_add_u32 v191, v191, 3, v15
    v_lshl_add_u32 v191, v3, 1, v191
    v_add_u32 v191, s62, v191

    buffer_load_dword v88, v217, s[32:35], s41 offen sc1
    buffer_load_dword v89, v217, s[32:35], s42 offen sc1
    buffer_load_dword v90, v217, s[32:35], s43 offen sc1
    buffer_load_dword v91, v217, s[32:35], s44 offen sc1
    s_barrier
    ds_read_b64_tr_b16 v[120:121], v24 offset:0
    ds_read_b64_tr_b16 v[122:123], v24 offset:512
    ds_read_b64_tr_b16 v[124:125], v24 offset:4096
    ds_read_b64_tr_b16 v[126:127], v24 offset:4608
    ds_read_b64_tr_b16 v[128:129], v24 offset:8192
    ds_read_b64_tr_b16 v[130:131], v24 offset:8704
    ds_read_b64_tr_b16 v[132:133], v24 offset:12288
    ds_read_b64_tr_b16 v[134:135], v24 offset:12800
    ds_read_b64_tr_b16 v[48:49], v24 offset:16384
    ds_read_b64_tr_b16 v[50:51], v24 offset:16896
    ds_read_b64_tr_b16 v[52:53], v24 offset:20480
    ds_read_b64_tr_b16 v[54:55], v24 offset:20992

    buffer_load_dword v92, v217, s[32:35], s41 offen sc1
    buffer_load_dword v93, v217, s[32:35], s42 offen sc1
    buffer_load_dword v94, v217, s[32:35], s43 offen sc1
    buffer_load_dword v95, v217, s[32:35], s44 offen sc1
    L_g3:
    s_waitcnt vmcnt(4)

    v_xor_b32 v88, s6, v88
    v_xor_b32 v89, s6, v89
    v_xor_b32 v90, s6, v90
    v_xor_b32 v91, s6, v91
    v_or_b32 v29, v88, v89
    v_or3_b32 v29, v29, v90, v91
    v_and_b32 v29, v6, v29
    v_cmp_ne_u32 vcc, 0, v29
    s_cbranch_vccz L_g3_ok
    s_sub_u32 s61, s61, 1
    s_cbranch_scc1 L_exit

    buffer_load_dword v88, v217, s[32:35], s41 offen sc1
    buffer_load_dword v89, v217, s[32:35], s42 offen sc1
    buffer_load_dword v90, v217, s[32:35], s43 offen sc1
    buffer_load_dword v91, v217, s[32:35], s44 offen sc1
    s_waitcnt vmcnt(4)
    v_xor_b32 v92, s6, v92
    v_xor_b32 v93, s6, v93
    v_xor_b32 v94, s6, v94
    v_xor_b32 v95, s6, v95
    v_or_b32 v29, v92, v93
    v_or3_b32 v29, v29, v94, v95
    v_and_b32 v29, v6, v29
    v_cmp_ne_u32 vcc, 0, v29
    s_cbranch_vccz L_g3_okb
    buffer_load_dword v92, v217, s[32:35], s41 offen sc1
    buffer_load_dword v93, v217, s[32:35], s42 offen sc1
    buffer_load_dword v94, v217, s[32:35], s43 offen sc1
    buffer_load_dword v95, v217, s[32:35], s44 offen sc1
    s_branch L_g3
L_g3_okb:
    v_mul_f32 v192, v224, v92
    v_fmac_f32 v192, v225, v93
    v_fmac_f32 v192, v226, v94
    v_fmac_f32 v192, v227, v95
    s_branch L_g3_done
L_g3_ok:
    v_mul_f32 v192, v224, v88
    v_fmac_f32 v192, v225, v89
    v_fmac_f32 v192, v226, v90
    v_fmac_f32 v192, v227, v91
L_g3_done:
    v_cvt_pk_bf16_f32 v192, v192, v192
    ds_write_b16 v188, v192 offset:1088
    ds_read_b128 v[136:139], v185 offset:320
    ds_read_b128 v[140:143], v185 offset:384
    ds_read_b32 v184, v186 offset:48
    s_waitcnt lgkmcnt(0)
    s_barrier

    ds_read_b128 v[196:199], v187 offset:1088
    ds_read_b128 v[200:203], v187 offset:1152
    ds_read_b128 v[204:207], v187 offset:1216
    ds_read_b128 v[208:211], v187 offset:1280
    v_mfma_f32_16x16x32_bf16 v[148:151], v[48:51], v[136:139], 0
    v_mfma_f32_16x16x32_bf16 v[148:151], v[52:55], v[140:143], v[148:151]
    v_sub_f32 v12, 1.0, v184
    s_waitcnt lgkmcnt(3)
    v_mfma_f32_16x16x32_bf16 v[144:147], v[120:123], v[196:199], 0
    s_waitcnt lgkmcnt(2)
    v_mfma_f32_16x16x32_bf16 v[144:147], v[124:127], v[200:203], v[144:147]
    s_waitcnt lgkmcnt(1)
    v_mfma_f32_16x16x32_bf16 v[144:147], v[128:131], v[204:207], v[144:147]
    s_waitcnt lgkmcnt(0)
    v_mfma_f32_16x16x32_bf16 v[144:147], v[132:135], v[208:211], v[144:147]
    v_mul_f32 v148, v12, v148
    v_mul_f32 v149, v12, v149
    v_mul_f32 v150, v12, v150
    v_mul_f32 v151, v12, v151
    s_nop 3
    v_fma_f32 v144, v184, v144, v148
    v_fma_f32 v145, v184, v145, v149
    v_fma_f32 v146, v184, v146, v150
    v_fma_f32 v147, v184, v147, v151
    v_bfi_b32 v144, v6, s6, v144
    v_bfi_b32 v145, v6, s6, v145
    v_bfi_b32 v146, v6, s6, v146
    v_bfi_b32 v147, v6, s6, v147
    s_mov_b32 exec_lo, 0x00030003
    s_mov_b32 exec_hi, 0x00030003
    buffer_store_dwordx4 v[144:147], v189, s[32:35], s48 offen sc1
    s_mov_b64 exec, -1
    s_lshl_b32 s62, s5, 2
    s_cmp_lg_u32 s62, s4
    s_cbranch_scc1 L_done

    buffer_load_dwordx4 v[88:91], v190, s[32:35], s50 offen sc1
    buffer_load_dwordx4 v[92:95], v190, s[32:35], s51 offen sc1
    buffer_load_dwordx4 v[96:99], v190, s[32:35], s52 offen sc1
    buffer_load_dwordx4 v[100:103], v190, s[32:35], s53 offen sc1
    buffer_load_dwordx4 v[104:107], v190, s[32:35], s50 offen sc1
    buffer_load_dwordx4 v[108:111], v190, s[32:35], s51 offen sc1
    buffer_load_dwordx4 v[112:115], v190, s[32:35], s52 offen sc1
    buffer_load_dwordx4 v[116:119], v190, s[32:35], s53 offen sc1
L_g4:
    s_waitcnt vmcnt(4)
    v_xor_b32 v88, s6, v88
    v_xor_b32 v89, s6, v89
    v_xor_b32 v90, s6, v90
    v_xor_b32 v91, s6, v91
    v_xor_b32 v92, s6, v92
    v_xor_b32 v93, s6, v93
    v_xor_b32 v94, s6, v94
    v_xor_b32 v95, s6, v95
    v_xor_b32 v96, s6, v96
    v_xor_b32 v97, s6, v97
    v_xor_b32 v98, s6, v98
    v_xor_b32 v99, s6, v99
    v_xor_b32 v100, s6, v100
    v_xor_b32 v101, s6, v101
    v_xor_b32 v102, s6, v102
    v_xor_b32 v103, s6, v103
    v_or_b32 v29, v88, v89
    v_or3_b32 v29, v29, v90, v91
    v_or3_b32 v29, v29, v92, v93
    v_or3_b32 v29, v29, v94, v95
    v_or3_b32 v29, v29, v96, v97
    v_or3_b32 v29, v29, v98, v99
    v_or3_b32 v29, v29, v100, v101
    v_or3_b32 v29, v29, v102, v103
    v_and_b32 v29, v6, v29
    v_cmp_ne_u32 vcc, 0, v29
    s_cbranch_vccz L_g4_ok
    s_sub_u32 s61, s61, 1
    s_cbranch_scc1 L_exit

    buffer_load_dwordx4 v[88:91], v190, s[32:35], s50 offen sc1
    buffer_load_dwordx4 v[92:95], v190, s[32:35], s51 offen sc1
    buffer_load_dwordx4 v[96:99], v190, s[32:35], s52 offen sc1
    buffer_load_dwordx4 v[100:103], v190, s[32:35], s53 offen sc1
    s_waitcnt vmcnt(4)
    v_xor_b32 v104, s6, v104
    v_xor_b32 v105, s6, v105
    v_xor_b32 v106, s6, v106
    v_xor_b32 v107, s6, v107
    v_xor_b32 v108, s6, v108
    v_xor_b32 v109, s6, v109
    v_xor_b32 v110, s6, v110
    v_xor_b32 v111, s6, v111
    v_xor_b32 v112, s6, v112
    v_xor_b32 v113, s6, v113
    v_xor_b32 v114, s6, v114
    v_xor_b32 v115, s6, v115
    v_xor_b32 v116, s6, v116
    v_xor_b32 v117, s6, v117
    v_xor_b32 v118, s6, v118
    v_xor_b32 v119, s6, v119
    v_or_b32 v29, v104, v105
    v_or3_b32 v29, v29, v106, v107
    v_or3_b32 v29, v29, v108, v109
    v_or3_b32 v29, v29, v110, v111
    v_or3_b32 v29, v29, v112, v113
    v_or3_b32 v29, v29, v114, v115
    v_or3_b32 v29, v29, v116, v117
    v_or3_b32 v29, v29, v118, v119
    v_and_b32 v29, v6, v29
    v_cmp_ne_u32 vcc, 0, v29
    s_cbranch_vccz L_g4_okb
    buffer_load_dwordx4 v[104:107], v190, s[32:35], s50 offen sc1
    buffer_load_dwordx4 v[108:111], v190, s[32:35], s51 offen sc1
    buffer_load_dwordx4 v[112:115], v190, s[32:35], s52 offen sc1
    buffer_load_dwordx4 v[116:119], v190, s[32:35], s53 offen sc1
    s_branch L_g4
L_g4_okb:
    v_add_f32 v104, v104, v108
    v_add_f32 v112, v112, v116
    v_add_f32 v105, v105, v109
    v_add_f32 v113, v113, v117
    v_add_f32 v106, v106, v110
    v_add_f32 v114, v114, v118
    v_add_f32 v107, v107, v111
    v_add_f32 v115, v115, v119
    v_add_f32 v212, v104, v112
    v_add_f32 v213, v105, v113
    v_add_f32 v214, v106, v114
    v_add_f32 v215, v107, v115
    s_branch L_g4_sum
L_g4_ok:
    v_add_f32 v88, v88, v92
    v_add_f32 v96, v96, v100
    v_add_f32 v89, v89, v93
    v_add_f32 v97, v97, v101
    v_add_f32 v90, v90, v94
    v_add_f32 v98, v98, v102
    v_add_f32 v91, v91, v95
    v_add_f32 v99, v99, v103
    v_add_f32 v212, v88, v96
    v_add_f32 v213, v89, v97
    v_add_f32 v214, v90, v98
    v_add_f32 v215, v91, v99
L_g4_sum:
    s_nop 0
    v_permlane32_swap_b32 v212, v214
    v_permlane32_swap_b32 v213, v215
    v_add_f32 v212, v212, v214
    v_add_f32 v213, v213, v215
    s_nop 1
    v_permlane16_swap_b32 v212, v213
    v_add_f32 v212, v212, v213
    s_nop 1
    v_add_f32_dpp v212, v212, v212 row_ror:8 row_mask:0xf bank_mask:0xf
    v_cvt_pk_bf16_f32 v212, v212, v212
    s_mov_b32 exec_lo, 0x00ff00ff
    s_mov_b32 exec_hi, 0x00ff00ff
    global_store_short v191, v212, s[28:29]
    s_or_b32 s62, s5, s66
    s_cmp_lg_u32 s62, 0
    s_cbranch_scc1 L_done
    s_mov_b64 exec, 1
    v_mov_b32 v12, 0
    v_mov_b32 v13, s7
    global_store_dword v12, v13, s[30:31] sc1
    L_done:

L_exit:
    s_endpgm
L_codeend:
.section .rodata,"a"
.p2align 6
.amdhsa_kernel gated_mix__sliding_block_cached__glu_gated_reglu__decode_kernel
  .amdhsa_next_free_vgpr 228
  .amdhsa_next_free_sgpr 102
  .amdhsa_accum_offset 228
  .amdhsa_group_segment_fixed_size 0
  .amdhsa_kernarg_size 104
  .amdhsa_user_sgpr_count 2
  .amdhsa_user_sgpr_kernarg_segment_ptr 1
  .amdhsa_system_sgpr_workgroup_id_x 1
  .amdhsa_float_denorm_mode_32 3
.end_amdhsa_kernel
```
